```python
import torch

def _softmax(x, axis=-1):
    return torch.softmax(x, dim=axis)

def _gelu(x):
    return torch.nn.functional.gelu(x, approximate='tanh')

def _silu(x):
    return torch.nn.functional.silu(x)

def _sigmoid(x):
    return torch.sigmoid(x)

def _layernorm(x, axis=-1, eps=1e-05):
    m = x.mean(dim=axis, keepdim=True)
    v = x.var(dim=axis, keepdim=True, unbiased=False)
    return (x - m) / torch.sqrt(v + eps)

def _scatter_add(tgt, idx, src, axis=0):
    return tgt.clone().index_add_(axis, idx, src)

def _segment_sum(src, seg, n):
    out = torch.zeros((n,) + src.shape[1:], dtype=src.dtype)
    return out.index_add_(0, seg, src)

def _pad(x, pw):
    flat = tuple((v for pair in reversed(pw) for v in pair))
    return torch.nn.functional.pad(x, flat)
kernel_name = 'standalone__tensor_product_equiv_equiformer__graph'

def setup_inputs():

    _w = lambda a: (lambda t: t.to(torch.bfloat16) if t.is_floating_point() else t)(torch.as_tensor(a))
    N, deg, C, De = (10000, 64, 64, max(0, 1))
    E = N * deg
    src = (lambda lo, hi, *s: torch.randint(lo, hi, s))(0, N, E).to(torch.int64)
    dst = (lambda lo, hi, *s: torch.randint(lo, hi, s))(0, N, E).to(torch.int64)
    rvec = (lambda *s: torch.randn(*s, dtype=torch.bfloat16) * 0.05)(E, 3).to(float)
    rn = (torch.linalg.norm(rvec, dim=-1, keepdim=True) + 1e-06).to(float)
    rhat = (rvec / rn).to(float)
    eps = torch.zeros((3, 3, 3), dtype=float)
    eps[0, 1, 2] = eps[1, 2, 0] = eps[2, 0, 1] = 1.0
    eps[0, 2, 1] = eps[2, 1, 0] = eps[1, 0, 2] = -1.0
    return {'x': _w((lambda *s: torch.randn(*s, dtype=torch.bfloat16) * 0.4)(N, 4 * C).to(float)), 'rhat': _w(rhat), 'e_attr': _w((lambda *s: torch.randn(*s, dtype=torch.bfloat16) * 0.4)(E, De).to(float)), 'src': _w(src), 'dst': _w(dst), 'w_rad': _w((lambda *s: torch.randn(*s, dtype=torch.bfloat16) * 0.4)(De, 5 * C).to(float)), 'w_si0': _w((lambda *s: torch.randn(*s, dtype=torch.bfloat16) * 0.4)(2 * C, C).to(float)), 'w_si1': _w((lambda *s: torch.randn(*s, dtype=torch.bfloat16) * 0.05)(3 * C, C).to(float)), 'cg_eps': _w(eps)}

def reference(x, rhat, e_attr, src, dst, w_rad, w_si0, w_si1, cg_eps):
    N = x.shape[0]
    C = w_si0.shape[1]
    E = rhat.shape[0]
    x0 = x[:, :C].clone()
    x1 = x[:, C:].reshape(N, 3, C)
    R = (e_attr @ w_rad).reshape(E, 5, C)
    f0 = x0[src]
    f1 = x1[src]
    Y1 = rhat
    p00_0 = f0 * R[:, 0, :]
    p11_0 = torch.einsum('ejc,ej->ec', f1, Y1) * R[:, 1, :]
    p01_1 = torch.einsum('ec,ej->ejc', f0, Y1) * R[:, 2, :][:, None, :]
    p10_1 = f1 * R[:, 3, :][:, None, :]
    p11_1 = torch.einsum('ijk,ekc,ej->eic', cg_eps, f1, Y1) * R[:, 4, :][:, None, :]
    m0 = torch.concatenate([p00_0, p11_0], axis=-1) @ w_si0
    m1 = torch.einsum('ejp,pc->ejc', torch.concatenate([p01_1, p10_1, p11_1], axis=-1), w_si1)
    agg0 = _segment_sum(m0, dst, N)
    agg1 = _segment_sum(m1.reshape(E, 3 * C), dst, N).reshape(N, 3, C)
    gate = _sigmoid(agg0)
    out1 = agg1 * gate[:, None, :]
    return torch.concatenate([agg0, out1.reshape(N, 3 * C)], axis=-1)
```

```asm
; @launch grid=(256,1,1) block=(768,1,1) lds=159312
.amdgcn_target "amdgcn-amd-amdhsa--gfx950"
.text
.globl standalone__tensor_product_equiv_equiformer__graph_kernel
.p2align 8
.type standalone__tensor_product_equiv_equiformer__graph_kernel,@function
standalone__tensor_product_equiv_equiformer__graph_kernel:
    s_cmp_ge_u32 s2, 256
    s_cbranch_scc1 F_end
    s_load_dwordx8 s[4:11], s[0:1], 8
    s_load_dwordx4 s[12:15], s[0:1], 40
    s_load_dwordx2 s[16:17], s[0:1], 56
    s_load_dwordx2 s[18:19], s[0:1], 80
    s_load_dwordx2 s[20:21], s[0:1], 0
    s_load_dwordx2 s[24:25], s[0:1], 72
    s_load_dwordx2 s[28:29], s[0:1], 88
    s_getpc_b64 s[60:61]
F_pc:
    s_bfe_u32 s3, s2, 0x20003
    s_lshl_b32 s3, s3, 7
    v_lshl_add_u32 v2, v0, 9, s3
    v_cmp_gt_u32 vcc, F_last-F_pc+124, v2
    v_min_u32 v2, F_last-F_pc, v2
    s_and_saveexec_b64 s[62:63], vcc
    s_cbranch_execz F_notouch
    global_load_dword v166, v2, s[60:61]
F_notouch:
    s_mov_b64 exec, s[62:63]
    v_lshrrev_b32 v1, 6, v0
    s_mul_i32 s3, s2, 10000
    v_readfirstlane_b32 s33, v1
    s_mov_b32 s30, 8716288
    s_mov_b32 s31, 0x20000
    s_mov_b32 s22, 5120000
    s_mov_b32 s23, 0x20000
    s_mov_b32 s26, 5120000
    s_mov_b32 s27, 0x20000
    s_and_b32 s39, s2, 7
    s_lshl_b32 s39, s39, 5
    s_lshr_b32 s38, s2, 3
    s_or_b32 s39, s39, s38
    s_lshr_b32 s36, s39, 2
    s_lshl_b32 s36, s36, 4
    s_bfe_u32 s38, s39, 0x10001
    s_lshl_b32 s38, s38, 10
    s_add_u32 s36, s36, s38
    s_and_b32 s38, s39, 1
    s_lshl_b32 s38, s38, 3
    s_add_u32 s36, s36, s38
    s_add_u32 s36, s36, 8192000
    s_cmp_ge_u32 s33, 10
    s_cbranch_scc1 F_helper
    v_lshl_add_u32 v64, v0, 4, s3
    v_cmp_gt_u32 vcc, 625, v0
    v_lshrrev_b32 v65, 1, v64
    v_add_u32 v66, v64, v65
    s_mov_b64 exec, vcc
    s_mov_b64 s[54:55], vcc
    s_waitcnt lgkmcnt(0)
    global_load_dwordx4 v[22:25], v64, s[10:11]
    s_barrier
    global_load_dwordx4 v[26:29], v64, s[8:9]
    global_load_dwordx2 v[30:31], v65, s[6:7]
    global_load_dwordx3 v[32:34], v66, s[4:5]
    global_load_dwordx3 v[36:38], v66, s[4:5] offset:12
    s_mov_b64 exec, -1
F_early:
    v_and_b32 v11, 15, v0
    v_lshrrev_b32 v1, 4, v0
    v_mad_u32_u24 v5, v11, 48, v1
    v_mul_u32_u24 v10, 2500, v5
    v_lshlrev_b32 v12, 3, v0
    v_add_u32 v12, 41024, v12
    s_lshl_b32 s3, s33, 4
    v_add_lshl_u32 v14, v11, s3, 2
    s_mul_i32 s38, s33, 3328
    s_add_u32 s38, s38, 1088
    v_bfe_u32 v1, v0, 5, 1
    v_lshl_add_u32 v19, v1, 4, s38
    v_lshl_add_u32 v20, v1, 5, s38
    v_and_b32 v1, 12, v0
    v_add_u32 v20, v20, v1
    v_lshlrev_b32 v1, 2, v0
    v_min_u32 v1, 1084, v1
    v_mov_b32 v2, 0
    v_mov_b32 v3, 0
    ds_write_b32 v1, v2 offset:0
    v_mov_b32 v1, 90176
    ds_write_b64 v1, v[2:3]
    v_lshl_add_u32 v1, v11, 2, s38
    v_mov_b32 v2, 0x1800ffff
    ds_write_b32 v1, v2
    s_mov_b32 s66, 0x40000
    s_mov_b64 s[72:73], 0
    v_lshl_add_u32 v15, v5, 11, s36
    v_mov_b32 v4, 0
    v_cmp_gt_u32 s[44:45], s30, v15
    s_mul_i32 s3, s2, 32000
    v_lshl_add_u32 v75, v0, 4, s3
    v_add_u32 v76, 12288, v75
    v_add_u32 v77, 24576, v75
    v_lshlrev_b32 v79, 4, v0
    v_add_u32 v79, 41024, v79
    s_movk_i32 s3, 464
    v_cmp_gt_u32 s[52:53], s3, v0
    s_mov_b32 s70, 0x88888888
    s_mov_b32 s71, 0x88888888
    v_mov_b32 v13, 4
    s_movk_i32 s37, 512
    s_mov_b32 s34, 0
    s_movk_i32 s35, 32
    s_mov_b32 s1, 0x33333334
    s_movk_i32 s32, 192
    s_mov_b64 s[64:65], -1
    s_mov_b32 s40, 0xc000ffff
    s_mov_b32 s69, 0x3fc000
    s_mov_b32 s67, 1
    v_and_b32 v1, 31, v0
    v_lshlrev_b32 v16, 2, v1
    v_and_b32 v3, 3, v0
    v_lshlrev_b32 v1, 17, v3
    v_sub_u32 v17, 41024, v1
    v_bfe_u32 v1, v0, 4, 1
    v_mul_u32_u24 v1, 0x5555, v1
    v_add_u32 v18, 0x8888, v1
    s_cmp_ge_u32 s33, 10
    s_cbranch_scc1 F_helper2
    v_and_b32 v74, 63, v0
    s_cmp_lt_u32 s33, 4
    s_cselect_b32 s14, s14, s16
    s_cselect_b32 s15, s15, s17
    s_cselect_b32 s3, 0, 4
    s_sub_u32 s3, s33, s3
    s_lshl_b32 s3, s3, 12
    v_lshl_add_u32 v72, v74, 4, s3
    v_lshrrev_b32 v73, 3, v74
    v_mul_u32_u24 v114, 160, v73
    s_lshl_b32 s3, s33, 5
    v_add_lshl_u32 v73, v73, s3, 1
    s_mul_i32 s3, s33, 5120
    s_add_u32 s3, s3, 90192
    v_and_b32 v106, 7, v0
    v_lshl_add_u32 v106, v106, 4, s3
    v_add_u32 v114, v114, v106
    v_mov_b32 v67, 1
    s_mov_b32 s68, 0xffff0000
    s_movk_i32 s50, 26843
    s_movk_i32 s48, 0x4100
    s_movk_i32 s49, 0x800
    s_mov_b64 exec, s[54:55]
    s_waitcnt vmcnt(4)
    v_lshlrev_b32_sdwa v40, 2, v22 dst_sel:DWORD dst_unused:UNUSED_PAD src0_sel:DWORD src1_sel:BYTE_0
    ds_add_rtn_u32 v44, v40, v67 offset:1344
    v_lshlrev_b32_sdwa v41, 2, v23 dst_sel:DWORD dst_unused:UNUSED_PAD src0_sel:DWORD src1_sel:BYTE_0
    ds_add_rtn_u32 v45, v41, v67 offset:1344
    v_lshlrev_b32_sdwa v42, 2, v24 dst_sel:DWORD dst_unused:UNUSED_PAD src0_sel:DWORD src1_sel:BYTE_0
    ds_add_rtn_u32 v46, v42, v67 offset:1344
    v_lshlrev_b32_sdwa v43, 2, v25 dst_sel:DWORD dst_unused:UNUSED_PAD src0_sel:DWORD src1_sel:BYTE_0
    ds_add_rtn_u32 v47, v43, v67 offset:1344
    s_waitcnt lgkmcnt(0)
    s_barrier
    v_lshrrev_b32 v68, 2, v23
    v_and_or_b32 v23, v68, s49, v23
    v_lshrrev_b32 v68, 2, v25
    v_and_or_b32 v25, v68, s49, v25
    v_mul_u32_u24_sdwa v22, s48, v22 dst_sel:DWORD dst_unused:UNUSED_PAD src0_sel:DWORD src1_sel:BYTE_1
    v_mul_u32_u24_sdwa v23, s48, v23 dst_sel:DWORD dst_unused:UNUSED_PAD src0_sel:DWORD src1_sel:BYTE_1
    v_mul_u32_u24_sdwa v24, s48, v24 dst_sel:DWORD dst_unused:UNUSED_PAD src0_sel:DWORD src1_sel:BYTE_1
    v_mul_u32_u24_sdwa v25, s48, v25 dst_sel:DWORD dst_unused:UNUSED_PAD src0_sel:DWORD src1_sel:BYTE_1
    v_and_b32 v22, 0xfc00, v22
    v_and_b32 v23, 0xfc00, v23
    v_and_b32 v24, 0xfc00, v24
    v_and_b32 v25, 0xfc00, v25
    s_barrier
    ds_read_b32 v40, v40 offset:2368
    ds_read_b32 v41, v41 offset:2368
    ds_read_b32 v42, v42 offset:2368
    ds_read_b32 v43, v43 offset:2368
    s_waitcnt lgkmcnt(0)
    s_load_dword s43, s[18:19], 0
    s_mov_b32 s3, 41024
    v_add_u32 v40, v40, v44
    v_mul_u32_u24 v68, 52429, v40
    v_lshrrev_b32 v68, 18, v68
    v_mad_u32_u24 v40, v40, 3, v68
    v_lshl_add_u32 v40, v40, 2, s3
    v_add_u32 v41, v41, v45
    v_mul_u32_u24 v68, 52429, v41
    v_lshrrev_b32 v68, 18, v68
    v_mad_u32_u24 v41, v41, 3, v68
    v_lshl_add_u32 v41, v41, 2, s3
    v_add_u32 v42, v42, v46
    v_mul_u32_u24 v68, 52429, v42
    v_lshrrev_b32 v68, 18, v68
    v_mad_u32_u24 v42, v42, 3, v68
    v_lshl_add_u32 v42, v42, 2, s3
    v_add_u32 v43, v43, v47
    v_mul_u32_u24 v68, 52429, v43
    v_lshrrev_b32 v68, 18, v68
    v_mad_u32_u24 v43, v43, 3, v68
    v_lshl_add_u32 v43, v43, 2, s3
    s_waitcnt vmcnt(3)
    v_mul_u32_u24 v50, s50, v26
    v_lshlrev_b32_sdwa v50, 6, v50 dst_sel:DWORD dst_unused:UNUSED_PAD src0_sel:DWORD src1_sel:BYTE_3
    v_or_b32 v50, v50, v22
    v_lshl_or_b32 v50, v50, 16, v26
    ds_write_b32 v40, v50 offset:8
    v_mul_u32_u24 v54, s50, v27
    v_lshlrev_b32_sdwa v54, 6, v54 dst_sel:DWORD dst_unused:UNUSED_PAD src0_sel:DWORD src1_sel:BYTE_3
    v_or_b32 v54, v54, v23
    v_lshl_or_b32 v54, v54, 16, v27
    ds_write_b32 v41, v54 offset:8
    v_mul_u32_u24 v58, s50, v28
    v_lshlrev_b32_sdwa v58, 6, v58 dst_sel:DWORD dst_unused:UNUSED_PAD src0_sel:DWORD src1_sel:BYTE_3
    v_or_b32 v58, v58, v24
    v_lshl_or_b32 v58, v58, 16, v28
    ds_write_b32 v42, v58 offset:8
    v_mul_u32_u24 v62, s50, v29
    v_lshlrev_b32_sdwa v62, 6, v62 dst_sel:DWORD dst_unused:UNUSED_PAD src0_sel:DWORD src1_sel:BYTE_3
    v_or_b32 v62, v62, v25
    v_lshl_or_b32 v62, v62, 16, v29
    ds_write_b32 v43, v62 offset:8
    s_waitcnt vmcnt(1)
    v_lshlrev_b32 v68, 16, v30
    v_lshlrev_b32 v69, 16, v32
    v_and_b32 v70, s68, v32
    v_lshlrev_b32 v71, 16, v33
    v_mul_f32 v69, v68, v69
    v_mul_f32 v70, v68, v70
    v_mul_f32 v71, v68, v71
    v_cvt_pk_bf16_f32 v48, v68, v69
    v_cvt_pk_bf16_f32 v49, v70, v71
    ds_write2_b32 v40, v48, v49 offset0:0 offset1:1
    v_and_b32 v68, s68, v30
    v_and_b32 v69, s68, v33
    v_lshlrev_b32 v70, 16, v34
    v_and_b32 v71, s68, v34
    v_mul_f32 v69, v68, v69
    v_mul_f32 v70, v68, v70
    v_mul_f32 v71, v68, v71
    v_cvt_pk_bf16_f32 v52, v68, v69
    v_cvt_pk_bf16_f32 v53, v70, v71
    ds_write2_b32 v41, v52, v53 offset0:0 offset1:1
    s_waitcnt vmcnt(0)
    v_lshlrev_b32 v68, 16, v31
    v_lshlrev_b32 v69, 16, v36
    v_and_b32 v70, s68, v36
    v_lshlrev_b32 v71, 16, v37
    v_mul_f32 v69, v68, v69
    v_mul_f32 v70, v68, v70
    v_mul_f32 v71, v68, v71
    v_cvt_pk_bf16_f32 v56, v68, v69
    v_cvt_pk_bf16_f32 v57, v70, v71
    ds_write2_b32 v42, v56, v57 offset0:0 offset1:1
    v_and_b32 v68, s68, v31
    v_and_b32 v69, s68, v37
    v_lshlrev_b32 v70, 16, v38
    v_and_b32 v71, s68, v38
    v_mul_f32 v69, v68, v69
    v_mul_f32 v70, v68, v70
    v_mul_f32 v71, v68, v71
    v_cvt_pk_bf16_f32 v60, v68, v69
    v_cvt_pk_bf16_f32 v61, v70, v71
    ds_write2_b32 v43, v60, v61 offset0:0 offset1:1
    s_mov_b64 exec, -1
    global_load_dwordx4 v[86:89], v72, s[14:15] offset:0
    global_load_dwordx4 v[90:93], v72, s[14:15] offset:1024
    global_load_dwordx4 v[94:97], v72, s[14:15] offset:2048
    global_load_dwordx4 v[98:101], v72, s[14:15] offset:3072
    global_load_ushort v102, v73, s[12:13] offset:0
    global_load_ushort v103, v73, s[12:13] offset:16
    global_load_ushort v104, v73, s[12:13] offset:32
    global_load_ushort v105, v73, s[12:13] offset:48
    s_waitcnt lgkmcnt(0)
    s_cmp_eq_u32 s43, 0
    s_cbranch_scc1 F_tagA
F_out:
    s_barrier
    ds_read_b128 v[22:25], v79 offset:0
    ds_read_b128 v[26:29], v79 offset:12288
    ds_read_b128 v[30:33], v79 offset:24576
    v_mov_b32 v68, s43
    s_waitcnt lgkmcnt(2)
    v_cndmask_b32 v25, v25, v68, s[70:71]
    global_store_dwordx4 v75, v[22:25], s[28:29] sc1
    s_waitcnt lgkmcnt(1)
    v_cndmask_b32 v29, v29, v68, s[70:71]
    global_store_dwordx4 v76, v[26:29], s[28:29] sc1
    s_mov_b64 exec, s[52:53]
    s_cbranch_execz F_out2
    s_waitcnt lgkmcnt(0)
    v_cndmask_b32 v33, v33, v68, s[70:71]
    global_store_dwordx4 v77, v[30:33], s[28:29] sc1
F_out2:
    s_mov_b64 exec, -1
    s_cmp_ge_u32 s33, 10
    s_cbranch_scc1 F_now
    s_cmp_lt_u32 s33, 8
    s_waitcnt vmcnt(3)
    s_cbranch_scc1 F_w3
    s_waitcnt vmcnt(2)
F_w3:
    v_lshlrev_b32 v102, 16, v102
    v_lshlrev_b32 v106, 16, v86
    v_and_b32 v107, s68, v86
    v_lshlrev_b32 v108, 16, v87
    v_and_b32 v109, s68, v87
    v_lshlrev_b32 v110, 16, v88
    v_and_b32 v111, s68, v88
    v_lshlrev_b32 v112, 16, v89
    v_and_b32 v113, s68, v89
    v_pk_mul_f32 v[106:107], v[106:107], v[102:103] op_sel_hi:[1,0]
    v_pk_mul_f32 v[108:109], v[108:109], v[102:103] op_sel_hi:[1,0]
    v_pk_mul_f32 v[110:111], v[110:111], v[102:103] op_sel_hi:[1,0]
    v_pk_mul_f32 v[112:113], v[112:113], v[102:103] op_sel_hi:[1,0]
    v_cvt_pk_bf16_f32 v86, v106, v107
    v_cvt_pk_bf16_f32 v87, v108, v109
    v_cvt_pk_bf16_f32 v88, v110, v111
    v_cvt_pk_bf16_f32 v89, v112, v113
    ds_write_b128 v114, v[86:89] offset:0
    v_lshlrev_b32 v103, 16, v103
    v_lshlrev_b32 v106, 16, v90
    v_and_b32 v107, s68, v90
    v_lshlrev_b32 v108, 16, v91
    v_and_b32 v109, s68, v91
    v_lshlrev_b32 v110, 16, v92
    v_and_b32 v111, s68, v92
    v_lshlrev_b32 v112, 16, v93
    v_and_b32 v113, s68, v93
    v_pk_mul_f32 v[106:107], v[106:107], v[102:103] op_sel:[0,1]
    v_pk_mul_f32 v[108:109], v[108:109], v[102:103] op_sel:[0,1]
    v_pk_mul_f32 v[110:111], v[110:111], v[102:103] op_sel:[0,1]
    v_pk_mul_f32 v[112:113], v[112:113], v[102:103] op_sel:[0,1]
    v_cvt_pk_bf16_f32 v90, v106, v107
    v_cvt_pk_bf16_f32 v91, v108, v109
    v_cvt_pk_bf16_f32 v92, v110, v111
    v_cvt_pk_bf16_f32 v93, v112, v113
    ds_write_b128 v114, v[90:93] offset:1280
    v_lshlrev_b32 v104, 16, v104
    v_lshlrev_b32 v106, 16, v94
    v_and_b32 v107, s68, v94
    v_lshlrev_b32 v108, 16, v95
    v_and_b32 v109, s68, v95
    v_lshlrev_b32 v110, 16, v96
    v_and_b32 v111, s68, v96
    v_lshlrev_b32 v112, 16, v97
    v_and_b32 v113, s68, v97
    v_pk_mul_f32 v[106:107], v[106:107], v[104:105] op_sel_hi:[1,0]
    v_pk_mul_f32 v[108:109], v[108:109], v[104:105] op_sel_hi:[1,0]
    v_pk_mul_f32 v[110:111], v[110:111], v[104:105] op_sel_hi:[1,0]
    v_pk_mul_f32 v[112:113], v[112:113], v[104:105] op_sel_hi:[1,0]
    v_cvt_pk_bf16_f32 v94, v106, v107
    v_cvt_pk_bf16_f32 v95, v108, v109
    v_cvt_pk_bf16_f32 v96, v110, v111
    v_cvt_pk_bf16_f32 v97, v112, v113
    ds_write_b128 v114, v[94:97] offset:2560
    v_lshlrev_b32 v105, 16, v105
    v_lshlrev_b32 v106, 16, v98
    v_and_b32 v107, s68, v98
    v_lshlrev_b32 v108, 16, v99
    v_and_b32 v109, s68, v99
    v_lshlrev_b32 v110, 16, v100
    v_and_b32 v111, s68, v100
    v_lshlrev_b32 v112, 16, v101
    v_and_b32 v113, s68, v101
    v_pk_mul_f32 v[106:107], v[106:107], v[104:105] op_sel:[0,1]
    v_pk_mul_f32 v[108:109], v[108:109], v[104:105] op_sel:[0,1]
    v_pk_mul_f32 v[110:111], v[110:111], v[104:105] op_sel:[0,1]
    v_pk_mul_f32 v[112:113], v[112:113], v[104:105] op_sel:[0,1]
    v_cvt_pk_bf16_f32 v98, v106, v107
    v_cvt_pk_bf16_f32 v99, v108, v109
    v_cvt_pk_bf16_f32 v100, v110, v111
    v_cvt_pk_bf16_f32 v101, v112, v113
    ds_write_b128 v114, v[98:101] offset:3840
F_now:
    s_waitcnt vmcnt(1)
    s_mov_b64 exec, s[44:45]
    buffer_load_dwordx2 v[4:5], v15, s[28:31], 0 offen sc1
F_b4:
    s_mov_b64 exec, s[44:45]
    s_waitcnt vmcnt(0) lgkmcnt(0)
    s_barrier
F_poll:
    v_cmp_ne_u32 vcc, s43, v5
    s_and_b64 exec, exec, vcc
    s_cbranch_scc1 F_repoll
F_polled:
    s_mov_b64 exec, -1
    v_and_b32 v1, 0xffff, v4
    v_lshrrev_b32 v2, 16, v4
    v_add3_u32 v6, v10, v1, s34
    v_subrev_u32 v2, s34, v2
    v_min_i32 v7, s35, v2
    v_cndmask_b32 v7, 0, v7, s[64:65]
    v_cmp_lt_i32 s[62:63], s35, v2
    v_add_u32_dpp v158, v6, v11 row_newbcast:0 row_mask:0xf bank_mask:0xf
    v_sub_u32_dpp v1, v7, v11 row_newbcast:0 row_mask:0xf bank_mask:0xf
    v_mul_hi_u32 v2, v158, s1
    v_cmp_lt_i32 s[44:45], 0, v1
    v_mad_u32_u24 v158, v158, 3, v2
    v_lshlrev_b32 v158, 2, v158
    v_or_b32 v129, 60, v158
    s_or_b64 exec, s[44:45], 1
    buffer_load_dword v129, v129, s[28:31], 0 offen
    buffer_load_dwordx3 v[126:128], v158, s[28:31], 0 offen
    s_mov_b64 exec, -1
    v_subrev_u32 v9, 16, v7
    v_add_u32 v8, 16, v6
    v_cmp_lt_i32 s[60:61], 0, v9
    v_lshlrev_b32 v15, 16, v0
    v_mov_b32 v3, 60
    v_mbcnt_lo_u32_b32 v1, s60, 0
    v_mbcnt_hi_u32_b32 v1, s61, v1
    v_and_b32 v2, 3, v1
    v_and_b32 v1, 28, v1
    v_lshl_add_u32 v1, v2, 6, v1
    v_cndmask_b32 v1, v3, v1, s[60:61]
    ds_permute_b32 v8, v1, v8
    ds_permute_b32 v9, v1, v9
    s_mov_b64 s[54:55], 0
    s_cmp_ge_u32 s33, 4
    s_cbranch_scc1 F_nor5
    v_add_u32_dpp v163, v6, v11 row_newbcast:5 row_mask:0xf bank_mask:0xf
    v_sub_u32_dpp v1, v7, v11 row_newbcast:5 row_mask:0xf bank_mask:0xf
    v_mul_hi_u32 v2, v163, s1
    v_cmp_lt_i32 s[54:55], 0, v1
    v_mad_u32_u24 v163, v163, 3, v2
    v_lshlrev_b32 v163, 2, v163
    v_or_b32 v149, 60, v163
    s_or_b64 exec, s[54:55], 1
    buffer_load_dword v149, v149, s[28:31], 0 offen
    buffer_load_dwordx3 v[146:148], v163, s[28:31], 0 offen
    s_mov_b64 exec, -1
F_nor5:
    s_mov_b64 s[56:57], 0
    s_bcnt1_i32_b64 s39, s[60:61]
    s_cbranch_scc0 F_nox0
    s_waitcnt lgkmcnt(0)
    s_nop 1
    v_add_u32_dpp v164, v8, v11 row_newbcast:0 row_mask:0xf bank_mask:0xf
    v_sub_u32_dpp v1, v9, v11 row_newbcast:0 row_mask:0xf bank_mask:0xf
    v_mul_hi_u32 v2, v164, s1
    v_cmp_lt_i32 s[56:57], 0, v1
    v_mad_u32_u24 v164, v164, 3, v2
    v_lshlrev_b32 v164, 2, v164
    v_or_b32 v153, 60, v164
    s_or_b64 exec, s[56:57], 1
    buffer_load_dword v153, v153, s[28:31], 0 offen
    buffer_load_dwordx3 v[150:152], v164, s[28:31], 0 offen
    s_mov_b64 exec, -1
F_nox0:
    v_add_u32_dpp v159, v6, v11 row_newbcast:1 row_mask:0xf bank_mask:0xf
    v_sub_u32_dpp v1, v7, v11 row_newbcast:1 row_mask:0xf bank_mask:0xf
    v_mul_hi_u32 v2, v159, s1
    v_cmp_lt_i32 s[46:47], 0, v1
    v_mad_u32_u24 v159, v159, 3, v2
    v_lshlrev_b32 v159, 2, v159
    v_or_b32 v133, 60, v159
    s_or_b64 exec, s[46:47], 1
    buffer_load_dword v133, v133, s[28:31], 0 offen
    buffer_load_dwordx3 v[130:132], v159, s[28:31], 0 offen
    s_mov_b64 exec, -1
    v_add_u32_dpp v160, v6, v11 row_newbcast:2 row_mask:0xf bank_mask:0xf
    v_sub_u32_dpp v1, v7, v11 row_newbcast:2 row_mask:0xf bank_mask:0xf
    v_mul_hi_u32 v2, v160, s1
    v_cmp_lt_i32 s[48:49], 0, v1
    v_mad_u32_u24 v160, v160, 3, v2
    v_lshlrev_b32 v160, 2, v160
    v_or_b32 v137, 60, v160
    s_or_b64 exec, s[48:49], 1
    buffer_load_dword v137, v137, s[28:31], 0 offen
    buffer_load_dwordx3 v[134:136], v160, s[28:31], 0 offen
    s_mov_b64 exec, -1
    v_add_u32_dpp v161, v6, v11 row_newbcast:3 row_mask:0xf bank_mask:0xf
    v_sub_u32_dpp v1, v7, v11 row_newbcast:3 row_mask:0xf bank_mask:0xf
    v_mul_hi_u32 v2, v161, s1
    v_cmp_lt_i32 s[50:51], 0, v1
    v_mad_u32_u24 v161, v161, 3, v2
    v_lshlrev_b32 v161, 2, v161
    v_or_b32 v141, 60, v161
    s_or_b64 exec, s[50:51], 1
    buffer_load_dword v141, v141, s[28:31], 0 offen
    buffer_load_dwordx3 v[138:140], v161, s[28:31], 0 offen
    s_mov_b64 exec, -1
    v_add_u32_dpp v162, v6, v11 row_newbcast:4 row_mask:0xf bank_mask:0xf
    v_sub_u32_dpp v1, v7, v11 row_newbcast:4 row_mask:0xf bank_mask:0xf
    v_mul_hi_u32 v2, v162, s1
    v_cmp_lt_i32 s[52:53], 0, v1
    v_mad_u32_u24 v162, v162, 3, v2
    v_lshlrev_b32 v162, 2, v162
    v_or_b32 v145, 60, v162
    s_or_b64 exec, s[52:53], 1
    buffer_load_dword v145, v145, s[28:31], 0 offen
    buffer_load_dwordx3 v[142:144], v162, s[28:31], 0 offen
    s_mov_b64 exec, -1
    s_mov_b64 exec, -1
    s_cmp_gt_u32 s39, 4
    s_cbranch_scc1 K2_x1
K2_x1_ret:
    s_cmp_lg_u64 s[62:63], 0
    s_cbranch_scc1 K2_setmore
K2_setmore_ret:
    s_cmp_eq_u32 s67, 0
    s_cbranch_scc1 F_nozero
    s_mov_b32 s67, 0
    v_mov_b64 v[22:23], 0
    v_mov_b64 v[24:25], 0
    v_mov_b64 v[26:27], 0
    v_mov_b64 v[28:29], 0
    v_mov_b64 v[30:31], 0
    v_mov_b64 v[32:33], 0
    v_mov_b64 v[34:35], 0
    v_mov_b64 v[36:37], 0
    v_mov_b64 v[38:39], 0
    v_mov_b64 v[40:41], 0
    v_mov_b64 v[42:43], 0
    v_mov_b64 v[44:45], 0
    v_mov_b64 v[46:47], 0
    v_mov_b64 v[48:49], 0
    v_mov_b64 v[50:51], 0
    v_mov_b64 v[52:53], 0
    v_mov_b64 v[54:55], 0
    v_mov_b64 v[56:57], 0
    v_mov_b64 v[58:59], 0
    v_mov_b64 v[60:61], 0
    v_mov_b64 v[62:63], 0
    v_mov_b64 v[64:65], 0
    v_mov_b64 v[66:67], 0
    v_mov_b64 v[68:69], 0
    v_mov_b64 v[70:71], 0
    v_mov_b64 v[72:73], 0
    v_mov_b64 v[74:75], 0
    v_mov_b64 v[76:77], 0
    v_mov_b64 v[78:79], 0
    v_mov_b64 v[80:81], 0
    v_mov_b64 v[82:83], 0
    v_mov_b64 v[84:85], 0
F_nozero:
    s_mov_b64 s[4:5], s[44:45]
    s_mov_b64 s[6:7], s[46:47]
    s_mov_b64 s[8:9], s[48:49]
    s_mov_b64 s[10:11], s[50:51]
    s_mov_b64 s[12:13], s[52:53]
    s_mov_b64 s[14:15], s[54:55]
    s_mov_b64 s[16:17], s[56:57]
F_sweep:
    s_waitcnt vmcnt(8)
    s_mov_b64 exec, s[14:15]
    v_and_or_b32 v1, v148, s69, v149
    v_cmpx_eq_u32 vcc, s43, v1
    v_bfe_u32 v163, v148, 20, 10
    v_add_u32 v1, 251658240, v15
    s_andn2_b64 s[14:15], s[14:15], exec
    ds_add_rtn_u32 v149, v163, v13 offset:0
    ds_write_b64 v12, v[146:147] offset:30720
    v_and_or_b32 v148, v148, s40, v1
    s_mov_b64 exec, s[16:17]
    v_and_or_b32 v1, v152, s69, v153
    v_cmpx_eq_u32 vcc, s43, v1
    v_bfe_u32 v164, v152, 20, 10
    v_add_u32 v1, 301989888, v15
    s_andn2_b64 s[16:17], s[16:17], exec
    ds_add_rtn_u32 v153, v164, v13 offset:0
    ds_write_b64 v12, v[150:151] offset:36864
    v_and_or_b32 v152, v152, s40, v1
    s_mov_b64 exec, s[4:5]
    v_and_or_b32 v1, v128, s69, v129
    v_cmpx_eq_u32 vcc, s43, v1
    v_bfe_u32 v158, v128, 20, 10
    v_add_u32 v1, 0, v15
    s_andn2_b64 s[4:5], s[4:5], exec
    ds_add_rtn_u32 v129, v158, v13 offset:0
    ds_write_b64 v12, v[126:127] offset:0
    v_and_or_b32 v128, v128, s40, v1
    s_waitcnt vmcnt(6)
    s_mov_b64 exec, s[6:7]
    v_and_or_b32 v1, v132, s69, v133
    v_cmpx_eq_u32 vcc, s43, v1
    v_bfe_u32 v159, v132, 20, 10
    v_add_u32 v1, 50331648, v15
    s_andn2_b64 s[6:7], s[6:7], exec
    ds_add_rtn_u32 v133, v159, v13 offset:0
    ds_write_b64 v12, v[130:131] offset:6144
    v_and_or_b32 v132, v132, s40, v1
    s_waitcnt vmcnt(4)
    s_mov_b64 exec, s[8:9]
    v_and_or_b32 v1, v136, s69, v137
    v_cmpx_eq_u32 vcc, s43, v1
    v_bfe_u32 v160, v136, 20, 10
    v_add_u32 v1, 100663296, v15
    s_andn2_b64 s[8:9], s[8:9], exec
    ds_add_rtn_u32 v137, v160, v13 offset:0
    ds_write_b64 v12, v[134:135] offset:12288
    v_and_or_b32 v136, v136, s40, v1
    s_waitcnt vmcnt(2)
    s_mov_b64 exec, s[10:11]
    v_and_or_b32 v1, v140, s69, v141
    v_cmpx_eq_u32 vcc, s43, v1
    v_bfe_u32 v161, v140, 20, 10
    v_add_u32 v1, 150994944, v15
    s_andn2_b64 s[10:11], s[10:11], exec
    ds_add_rtn_u32 v141, v161, v13 offset:0
    ds_write_b64 v12, v[138:139] offset:18432
    v_and_or_b32 v140, v140, s40, v1
    s_waitcnt vmcnt(0)
    s_mov_b64 exec, s[12:13]
    v_and_or_b32 v1, v144, s69, v145
    v_cmpx_eq_u32 vcc, s43, v1
    v_bfe_u32 v162, v144, 20, 10
    v_add_u32 v1, 201326592, v15
    s_andn2_b64 s[12:13], s[12:13], exec
    ds_add_rtn_u32 v145, v162, v13 offset:0
    ds_write_b64 v12, v[142:143] offset:24576
    v_and_or_b32 v144, v144, s40, v1
    s_or_b64 s[60:61], s[4:5], s[6:7]
    s_or_b64 s[60:61], s[60:61], s[8:9]
    s_or_b64 s[60:61], s[60:61], s[10:11]
    s_or_b64 s[60:61], s[60:61], s[12:13]
    s_or_b64 s[60:61], s[60:61], s[14:15]
    s_or_b64 s[60:61], s[60:61], s[16:17]
    s_cbranch_scc1 F_retry
    s_cmp_eq_u32 s33, 11
    s_cbranch_scc1 F_prefetch
F_prefetched:
    s_waitcnt lgkmcnt(0)
    s_andn2_b64 s[70:71], s[54:55], s[14:15]
    s_mov_b64 exec, s[70:71]
    v_cmpx_gt_u32 vcc, s32, v149
    v_mad_u32_u24 v2, v163, 52, v149
    s_xor_b64 s[70:71], s[70:71], exec
    ds_write_b32 v2, v148 offset:1088
    s_or_b64 s[72:73], s[72:73], s[70:71]
    s_andn2_b64 s[70:71], s[56:57], s[16:17]
    s_mov_b64 exec, s[70:71]
    v_cmpx_gt_u32 vcc, s32, v153
    v_mad_u32_u24 v2, v164, 52, v153
    s_xor_b64 s[70:71], s[70:71], exec
    ds_write_b32 v2, v152 offset:1088
    s_or_b64 s[72:73], s[72:73], s[70:71]
    s_andn2_b64 s[70:71], s[44:45], s[4:5]
    s_mov_b64 exec, s[70:71]
    v_cmpx_gt_u32 vcc, s32, v129
    v_mad_u32_u24 v2, v158, 52, v129
    s_xor_b64 s[70:71], s[70:71], exec
    ds_write_b32 v2, v128 offset:1088
    s_or_b64 s[72:73], s[72:73], s[70:71]
    s_andn2_b64 s[70:71], s[46:47], s[6:7]
    s_mov_b64 exec, s[70:71]
    v_cmpx_gt_u32 vcc, s32, v133
    v_mad_u32_u24 v2, v159, 52, v133
    s_xor_b64 s[70:71], s[70:71], exec
    ds_write_b32 v2, v132 offset:1088
    s_or_b64 s[72:73], s[72:73], s[70:71]
    s_andn2_b64 s[70:71], s[48:49], s[8:9]
    s_mov_b64 exec, s[70:71]
    v_cmpx_gt_u32 vcc, s32, v137
    v_mad_u32_u24 v2, v160, 52, v137
    s_xor_b64 s[70:71], s[70:71], exec
    ds_write_b32 v2, v136 offset:1088
    s_or_b64 s[72:73], s[72:73], s[70:71]
    s_andn2_b64 s[70:71], s[50:51], s[10:11]
    s_mov_b64 exec, s[70:71]
    v_cmpx_gt_u32 vcc, s32, v141
    v_mad_u32_u24 v2, v161, 52, v141
    s_xor_b64 s[70:71], s[70:71], exec
    ds_write_b32 v2, v140 offset:1088
    s_or_b64 s[72:73], s[72:73], s[70:71]
    s_andn2_b64 s[70:71], s[52:53], s[12:13]
    s_mov_b64 exec, s[70:71]
    v_cmpx_gt_u32 vcc, s32, v145
    v_mad_u32_u24 v2, v162, 52, v145
    s_xor_b64 s[70:71], s[70:71], exec
    ds_write_b32 v2, v144 offset:1088
    s_or_b64 s[72:73], s[72:73], s[70:71]
    s_cbranch_scc1 K2_setslow
K2_setslow_ret:
    s_mov_b64 exec, -1
    v_and_b32 v5, 63, v0
    v_lshl_add_u32 v5, v5, 2, s38
    v_mov_b32 v6, 1024
    s_waitcnt lgkmcnt(0)
    s_barrier
    s_cmp_lt_u32 s33, 4
    s_cselect_b32 s36, 64, 0
    s_cbranch_scc1 F_first
F_compact:
    ds_read_b32 v102, v14 offset:0
    ds_read_b64 v[6:7], v6
    ds_read_b32 v87, v5 offset:208
    ds_read_b32 v88, v5 offset:416
    ds_read_b32 v89, v5 offset:624
    ds_read_b32 v90, v5 offset:832
    ds_read_b32 v91, v5 offset:1040
    ds_read_b32 v92, v5 offset:1248
    ds_read_b32 v93, v5 offset:1456
    ds_read_b32 v94, v5 offset:1664
    ds_read_b32 v95, v5 offset:1872
    ds_read_b32 v96, v5 offset:2080
    ds_read_b32 v97, v5 offset:2288
    ds_read_b32 v98, v5 offset:2496
    ds_read_b32 v99, v5 offset:2704
    s_mov_b32 exec_lo, 0x00010001
    s_mov_b32 exec_hi, 0x00010001
    s_waitcnt lgkmcnt(13)
    v_max_u32 v102, s36, v102
    s_mov_b64 exec, -1
    v_mov_b32 v103, v102
    ds_read_b32 v100, v5 offset:2912
    ds_read_b32 v101, v5 offset:3120
    v_readfirstlane_b32 s39, v6
    v_readfirstlane_b32 s62, v7
    s_nop 1
    v_add_u32_dpp v103, v103, v103 row_shr:1 row_mask:0xf bank_mask:0xf
    s_nop 1
    v_add_u32_dpp v103, v103, v103 row_shr:2 row_mask:0xf bank_mask:0xf
    s_nop 1
    v_add_u32_dpp v103, v103, v103 row_shr:4 row_mask:0xf bank_mask:0xf
    s_nop 1
    v_add_u32_dpp v103, v103, v103 row_shr:8 row_mask:0xf bank_mask:0xf
    s_cmp_lg_u32 s39, 0
    s_cbranch_scc1 K2_goslow
    v_readlane_b32 s41, v103, 15
    v_sub_u32 v103, v103, v102
    v_mov_b32 v6, 0x1800ffff
    s_mov_b32 exec_hi, 0xffff
    v_add_u32 v7, s41, v5
    s_waitcnt lgkmcnt(0)
    v_add_u32_dpp v104, v103, v5 row_newbcast:1 row_mask:0xf bank_mask:0xf
    ds_write_b32 v104, v87
    v_add_u32_dpp v105, v103, v5 row_newbcast:2 row_mask:0xf bank_mask:0xf
    ds_write_b32 v105, v88
    v_add_u32_dpp v104, v103, v5 row_newbcast:3 row_mask:0xf bank_mask:0xf
    ds_write_b32 v104, v89
    v_add_u32_dpp v105, v103, v5 row_newbcast:4 row_mask:0xf bank_mask:0xf
    ds_write_b32 v105, v90
    v_add_u32_dpp v104, v103, v5 row_newbcast:5 row_mask:0xf bank_mask:0xf
    ds_write_b32 v104, v91
    v_add_u32_dpp v105, v103, v5 row_newbcast:6 row_mask:0xf bank_mask:0xf
    ds_write_b32 v105, v92
    v_add_u32_dpp v104, v103, v5 row_newbcast:7 row_mask:0xf bank_mask:0xf
    ds_write_b32 v104, v93
    v_add_u32_dpp v105, v103, v5 row_newbcast:8 row_mask:0xf bank_mask:0xf
    ds_write_b32 v105, v94
    v_add_u32_dpp v104, v103, v5 row_newbcast:9 row_mask:0xf bank_mask:0xf
    ds_write_b32 v104, v95
    v_add_u32_dpp v105, v103, v5 row_newbcast:10 row_mask:0xf bank_mask:0xf
    ds_write_b32 v105, v96
    v_add_u32_dpp v104, v103, v5 row_newbcast:11 row_mask:0xf bank_mask:0xf
    ds_write_b32 v104, v97
    v_add_u32_dpp v105, v103, v5 row_newbcast:12 row_mask:0xf bank_mask:0xf
    ds_write_b32 v105, v98
    v_add_u32_dpp v104, v103, v5 row_newbcast:13 row_mask:0xf bank_mask:0xf
    ds_write_b32 v104, v99
    v_add_u32_dpp v105, v103, v5 row_newbcast:14 row_mask:0xf bank_mask:0xf
    ds_write_b32 v105, v100
    v_add_u32_dpp v104, v103, v5 row_newbcast:15 row_mask:0xf bank_mask:0xf
    ds_write_b32 v104, v101
    ds_write_b32 v7, v6
    s_mov_b64 exec, -1
    s_sub_i32 s36, s41, 64
    s_mul_i32 s42, s41, 8
    s_lshr_b32 s42, s42, 4
    s_cmp_lt_u32 s33, 4
    s_cbranch_scc1 F_wfrag
    s_cmp_eq_u32 s41, 0
    s_cbranch_scc1 F_wfrag
F_first:
    s_setprio 3
    ds_read_b128 v[158:161], v19
    ds_read_b128 v[162:165], v19 offset:32
    ds_read2_b32 v[2:3], v20 offset0:0 offset1:4
    v_add_u32 v19, 64, v19
    v_add_u32 v20, 64, v20
    s_waitcnt lgkmcnt(0)
    v_mad_u32_u16 v158, v158, s37, v16
    v_mad_u32_u16 v159, v159, s37, v16
    v_mad_u32_u16 v160, v160, s37, v16
    v_mad_u32_u16 v161, v161, s37, v16
    v_mad_u32_u16 v162, v162, s37, v16
    v_mad_u32_u16 v163, v163, s37, v16
    v_mad_u32_u16 v164, v164, s37, v16
    v_mad_u32_u16 v165, v165, s37, v16
    v_mad_u32_u16 v2, v2, 8, v17 op_sel:[1,0,0,0]
    v_mad_u32_u16 v3, v3, 8, v17 op_sel:[1,0,0,0]
    buffer_load_dword v126, v158, s[20:23], 0 offen offset:0
    buffer_load_dword v134, v158, s[20:23], 0 offen offset:128
    buffer_load_dword v142, v158, s[20:23], 0 offen offset:256
    buffer_load_dword v150, v158, s[20:23], 0 offen offset:384
    buffer_load_dword v127, v159, s[20:23], 0 offen offset:0
    buffer_load_dword v135, v159, s[20:23], 0 offen offset:128
    buffer_load_dword v143, v159, s[20:23], 0 offen offset:256
    buffer_load_dword v151, v159, s[20:23], 0 offen offset:384
    buffer_load_dword v128, v160, s[20:23], 0 offen offset:0
    buffer_load_dword v136, v160, s[20:23], 0 offen offset:128
    buffer_load_dword v144, v160, s[20:23], 0 offen offset:256
    buffer_load_dword v152, v160, s[20:23], 0 offen offset:384
    buffer_load_dword v129, v161, s[20:23], 0 offen offset:0
    buffer_load_dword v137, v161, s[20:23], 0 offen offset:128
    buffer_load_dword v145, v161, s[20:23], 0 offen offset:256
    buffer_load_dword v153, v161, s[20:23], 0 offen offset:384
    buffer_load_dword v130, v162, s[20:23], 0 offen offset:0
    buffer_load_dword v138, v162, s[20:23], 0 offen offset:128
    buffer_load_dword v146, v162, s[20:23], 0 offen offset:256
    buffer_load_dword v154, v162, s[20:23], 0 offen offset:384
    buffer_load_dword v131, v163, s[20:23], 0 offen offset:0
    buffer_load_dword v139, v163, s[20:23], 0 offen offset:128
    buffer_load_dword v147, v163, s[20:23], 0 offen offset:256
    buffer_load_dword v155, v163, s[20:23], 0 offen offset:384
    buffer_load_dword v132, v164, s[20:23], 0 offen offset:0
    buffer_load_dword v140, v164, s[20:23], 0 offen offset:128
    buffer_load_dword v148, v164, s[20:23], 0 offen offset:256
    buffer_load_dword v156, v164, s[20:23], 0 offen offset:384
    buffer_load_dword v133, v165, s[20:23], 0 offen offset:0
    buffer_load_dword v141, v165, s[20:23], 0 offen offset:128
    buffer_load_dword v149, v165, s[20:23], 0 offen offset:256
    buffer_load_dword v157, v165, s[20:23], 0 offen offset:384
    s_cmp_lt_u32 s33, 4
    s_cbranch_scc1 F_compact
F_wfrag:
    v_bfe_u32 v6, v0, 4, 2
    v_bfe_u32 v7, v0, 2, 2
    v_lshl_add_u32 v8, v6, 3, v7
    v_bfe_u32 v7, v0, 2, 1
    v_lshl_add_u32 v6, v6, 2, v7
    v_bfe_u32 v7, v0, 3, 1
    v_lshl_add_u32 v6, v7, 6, v6
    s_and_b32 s3, s33, 3
    s_lshl_b32 s3, s3, 5
    s_add_u32 s3, s3, 90192
    v_and_b32 v7, 3, v0
    v_lshl_add_u32 v7, v7, 3, s3
    s_movk_i32 s3, 160
    v_mad_u32_u24 v6, v6, s3, v7
    v_mad_u32_u24 v8, v8, s3, v7
    ds_read_b64_tr_b16 v[86:87], v6 offset:0
    ds_read_b64_tr_b16 v[88:89], v6 offset:320
    ds_read_b64_tr_b16 v[90:91], v6 offset:2560
    ds_read_b64_tr_b16 v[92:93], v6 offset:2880
    ds_read_b64_tr_b16 v[94:95], v6 offset:5120
    ds_read_b64_tr_b16 v[96:97], v6 offset:5440
    ds_read_b64_tr_b16 v[98:99], v6 offset:7680
    ds_read_b64_tr_b16 v[100:101], v6 offset:8000
    ds_read_b64_tr_b16 v[102:103], v6 offset:20480
    ds_read_b64_tr_b16 v[104:105], v6 offset:20800
    ds_read_b64_tr_b16 v[106:107], v6 offset:23040
    ds_read_b64_tr_b16 v[108:109], v6 offset:23360
    ds_read_b64_tr_b16 v[110:111], v6 offset:25600
    ds_read_b64_tr_b16 v[112:113], v6 offset:25920
    ds_read_b64_tr_b16 v[114:115], v6 offset:28160
    ds_read_b64_tr_b16 v[116:117], v6 offset:28480
    ds_read_b64_tr_b16 v[118:119], v8 offset:40960
    ds_read_b64_tr_b16 v[120:121], v8 offset:41600
    ds_read_b64_tr_b16 v[122:123], v8 offset:46080
    ds_read_b64_tr_b16 v[124:125], v8 offset:46720
    v_and_b32 v1, 15, v0
    v_bfe_u32 v5, v0, 4, 2
    s_lshr_b32 s38, s33, 2
    s_mul_i32 s3, s38, 23040
    s_add_u32 s3, s3, 90192
    v_mul_u32_u24 v10, 1440, v1
    v_lshl_add_u32 v10, v5, 4, v10
    v_add_u32 v10, s3, v10
    s_mul_i32 s60, s38, 13312
    s_add_u32 s60, s60, 1088
    s_and_b32 s39, s33, 3
    s_lshl_b32 s3, s39, 5
    s_add_u32 s3, s3, s60
    v_mul_u32_u24 v11, 528, v1
    v_lshl_add_u32 v11, v5, 3, v11
    v_add_u32 v11, s3, v11
    s_mul_i32 s3, s33, 5760
    s_add_u32 s3, s3, 90192
    v_bfe_u32 v1, v0, 5, 1
    v_mul_u32_u24 v5, 1440, v1
    v_add3_u32 v14, v5, v16, s3
    v_add_u32 v12, v14, v16
    s_mul_i32 s3, s39, 1056
    s_add_u32 s3, s3, s60
    v_mul_u32_u24 v5, 528, v1
    v_lshl_add_u32 v5, v16, 2, v5
    v_add_u32 v15, s3, v5
    s_lshl_b32 s3, s38, 3
    s_add_u32 s3, s3, s39
    s_lshl_b32 s3, s3, 9
    s_add_u32 s3, s3, s2
    s_lshl_b32 s3, s3, 9
    v_lshl_add_u32 v5, v16, 2, s3
    v_lshl_add_u32 v5, v1, 17, v5
    s_lshl_b32 s60, s38, 2
    s_add_u32 s60, s60, 1040
    v_mov_b32 v1, 1032
    s_mov_b64 exec, 1
    s_waitcnt lgkmcnt(0)
    ds_add_u32 v1, v13
    s_mov_b64 exec, -1
    s_mul_i32 s3, s2, 128
    s_sub_u32 s3, 0x10000, s3
    s_mul_i32 s3, s3, s41
    s_lshr_b32 s3, s3, 16
    s_cmp_eq_u32 s33, 0
    s_cselect_b32 s4, s3, 0xc0000000
    s_cmp_eq_u32 s41, 0
    s_cbranch_scc1 K2_done
K2_loop:
    ds_read_b64_tr_b16 v[6:7], v2
    ds_read_b64_tr_b16 v[8:9], v3
    ds_read_b128 v[158:161], v19
    ds_read_b128 v[162:165], v19 offset:32
    ds_read2_b32 v[2:3], v20 offset0:0 offset1:4
    v_add_u32 v19, 64, v19
    v_add_u32 v20, 64, v20
    s_cmp_le_i32 s36, s4
    s_cbranch_scc1 F_pfB
F_pfB_ret:
    s_cmp_ge_i32 s36, s42
    s_cbranch_scc1 K2_prio
    s_setprio 2
K2_prio:
    s_waitcnt lgkmcnt(0)
    v_mad_u32_u16 v158, v158, s37, v16
    v_mad_u32_u16 v159, v159, s37, v16
    v_mad_u32_u16 v160, v160, s37, v16
    v_mad_u32_u16 v161, v161, s37, v16
    v_mad_u32_u16 v162, v162, s37, v16
    v_mad_u32_u16 v163, v163, s37, v16
    v_mad_u32_u16 v164, v164, s37, v16
    v_mad_u32_u16 v165, v165, s37, v16
    v_mad_u32_u16 v2, v2, 8, v17 op_sel:[1,0,0,0]
    v_mad_u32_u16 v3, v3, 8, v17 op_sel:[1,0,0,0]
    s_cmp_le_i32 s36, 0
    s_waitcnt vmcnt(0)
    v_smfmac_f32_32x32x32_bf16 v[22:37], v[6:9], v[126:133], v18
    v_smfmac_f32_32x32x32_bf16 v[38:53], v[6:9], v[134:141], v18
    v_smfmac_f32_32x32x32_bf16 v[54:69], v[6:9], v[142:149], v18
    v_smfmac_f32_32x32x32_bf16 v[70:85], v[6:9], v[150:157], v18
    s_cbranch_scc1 K2_done
    buffer_load_dword v126, v158, s[20:23], 0 offen offset:0
    buffer_load_dword v134, v158, s[20:23], 0 offen offset:128
    buffer_load_dword v142, v158, s[20:23], 0 offen offset:256
    buffer_load_dword v150, v158, s[20:23], 0 offen offset:384
    buffer_load_dword v127, v159, s[20:23], 0 offen offset:0
    buffer_load_dword v135, v159, s[20:23], 0 offen offset:128
    buffer_load_dword v143, v159, s[20:23], 0 offen offset:256
    buffer_load_dword v151, v159, s[20:23], 0 offen offset:384
    buffer_load_dword v128, v160, s[20:23], 0 offen offset:0
    buffer_load_dword v136, v160, s[20:23], 0 offen offset:128
    buffer_load_dword v144, v160, s[20:23], 0 offen offset:256
    buffer_load_dword v152, v160, s[20:23], 0 offen offset:384
    buffer_load_dword v129, v161, s[20:23], 0 offen offset:0
    buffer_load_dword v137, v161, s[20:23], 0 offen offset:128
    buffer_load_dword v145, v161, s[20:23], 0 offen offset:256
    buffer_load_dword v153, v161, s[20:23], 0 offen offset:384
    s_sub_i32 s36, s36, 64
    s_cmp_le_i32 s36, -32
    s_cbranch_scc1 K2_loop
    buffer_load_dword v130, v162, s[20:23], 0 offen offset:0
    buffer_load_dword v138, v162, s[20:23], 0 offen offset:128
    buffer_load_dword v146, v162, s[20:23], 0 offen offset:256
    buffer_load_dword v154, v162, s[20:23], 0 offen offset:384
    buffer_load_dword v131, v163, s[20:23], 0 offen offset:0
    buffer_load_dword v139, v163, s[20:23], 0 offen offset:128
    buffer_load_dword v147, v163, s[20:23], 0 offen offset:256
    buffer_load_dword v155, v163, s[20:23], 0 offen offset:384
    buffer_load_dword v132, v164, s[20:23], 0 offen offset:0
    buffer_load_dword v140, v164, s[20:23], 0 offen offset:128
    buffer_load_dword v148, v164, s[20:23], 0 offen offset:256
    buffer_load_dword v156, v164, s[20:23], 0 offen offset:384
    buffer_load_dword v133, v165, s[20:23], 0 offen offset:0
    buffer_load_dword v141, v165, s[20:23], 0 offen offset:128
    buffer_load_dword v149, v165, s[20:23], 0 offen offset:256
    buffer_load_dword v157, v165, s[20:23], 0 offen offset:384
    s_branch K2_loop
F_helper:
    s_cmp_eq_u32 s33, 10
    s_cbranch_scc1 F_scan0
    s_cmp_ge_u32 s2, 8
    s_cbranch_scc1 F_h1
    s_memrealtime s[46:47]
    v_mov_b32 v1, 0
    s_waitcnt lgkmcnt(0)
    s_mul_i32 s3, s46, 0x9e3779b1
    s_andn2_b32 s3, s3, 0x3fc000
    s_or_b32 s3, s3, 1
    v_mov_b32 v2, s3
    v_mov_b32 v3, 0
    s_mov_b64 exec, 1
    global_atomic_cmpswap v1, v[2:3], s[18:19] sc1
    s_mov_b64 exec, -1
F_h1:
    v_and_b32 v1, 63, v0
    v_lshlrev_b32 v1, 7, v1
    s_lshr_b32 s3, s2, 3
    s_lshl_b32 s38, s3, 9
    v_add_u32 v2, s38, v1
    s_mul_i32 s38, s3, 768
    v_add_u32 v3, s38, v1
    s_waitcnt lgkmcnt(0)
    s_mov_b64 exec, 15
    global_load_dword v166, v2, s[14:15]
    s_mov_b64 exec, 63
    global_load_dword v166, v3, s[16:17]
    s_mov_b64 exec, 31
    global_load_dword v166, v1, s[12:13]
    s_mov_b64 exec, -1
    s_barrier
    s_branch F_early
F_scan0:
    v_and_b32 v22, 63, v0
    v_lshlrev_b32 v23, 4, v22
    v_mov_b32 v26, 0
    v_mov_b32 v27, 0
    v_mov_b32 v28, 0
    v_mov_b32 v29, 0
    ds_write_b128 v23, v[26:29] offset:1344
    s_waitcnt lgkmcnt(0)
    s_barrier
    s_branch F_early
F_helper2:
    s_cmp_eq_u32 s33, 10
    s_cbranch_scc1 F_scan
    s_barrier
    s_barrier
    s_load_dword s43, s[18:19], 0
    s_waitcnt lgkmcnt(0)
    s_cmp_lg_u32 s43, 0
    s_cbranch_scc1 F_out
    s_branch F_tagA
F_scan:
    v_and_b32 v22, 63, v0
    v_lshlrev_b32 v23, 4, v22
    s_lshl_b32 s3, s2, 11
    s_add_u32 s3, s3, 8192000
    v_add_u32 v94, s3, v23
    v_and_b32 v24, 7, v22
    v_lshrrev_b32 v25, 3, v22
    v_lshlrev_b32 v25, 2, v25
    v_lshl_add_u32 v24, v24, 7, v25
    v_add_u32 v25, 2368, v24
    v_add_u32 v24, 1344, v24
    s_barrier
    ds_read2_b32 v[26:27], v24 offset0:0 offset1:8
    ds_read2_b32 v[28:29], v24 offset0:16 offset1:24
    s_waitcnt lgkmcnt(0)
    v_add_u32 v31, v26, v27
    v_add_u32 v32, v31, v28
    v_add_u32 v33, v32, v29
    v_mov_b32 v34, v33
    s_nop 1
    v_add_u32_dpp v34, v34, v34 row_shr:1 row_mask:0xf bank_mask:0xf
    s_nop 1
    v_add_u32_dpp v34, v34, v34 row_shr:2 row_mask:0xf bank_mask:0xf
    s_nop 1
    v_add_u32_dpp v34, v34, v34 row_shr:4 row_mask:0xf bank_mask:0xf
    s_nop 1
    v_add_u32_dpp v34, v34, v34 row_shr:8 row_mask:0xf bank_mask:0xf
    s_nop 1
    v_add_u32_dpp v34, v34, v34 row_bcast:15 row_mask:0xa bank_mask:0xf
    s_nop 1
    v_add_u32_dpp v34, v34, v34 row_bcast:31 row_mask:0xc bank_mask:0xf
    v_sub_u32 v38, v34, v33
    v_add_u32 v39, v38, v26
    ds_write2_b32 v25, v38, v39 offset0:0 offset1:8
    v_add_u32 v40, v38, v31
    v_add_u32 v41, v38, v32
    ds_write2_b32 v25, v40, v41 offset0:16 offset1:24
    s_waitcnt lgkmcnt(0)
    s_barrier
    s_load_dword s43, s[18:19], 0
    v_lshl_or_b32 v86, v26, 16, v38
    v_lshl_or_b32 v88, v27, 16, v39
    v_lshl_or_b32 v90, v28, 16, v40
    v_lshl_or_b32 v92, v29, 16, v41
    s_waitcnt lgkmcnt(0)
    s_cmp_eq_u32 s43, 0
    s_cbranch_scc1 F_tagD
F_tagD_ret:
    s_nop 1
    v_mov_b32 v87, s43
    v_mov_b32 v89, s43
    v_mov_b32 v91, s43
    v_mov_b32 v93, s43
    global_store_dwordx4 v94, v[86:89], s[28:29] sc1
    global_store_dwordx4 v94, v[90:93], s[28:29] offset:1024 sc1
    s_branch F_out
F_prefetch:
    s_mov_b64 exec, -1
    v_and_b32 v1, 63, v0
    s_mul_i32 s3, s2, 8192
    s_add_u32 s3, s3, 0
    v_lshl_add_u32 v2, v1, 7, s3
    buffer_load_dword v166, v2, s[20:23], 0 offen
    v_add_u32 v2, 8192, v2
    s_mov_b64 exec, -1
    s_branch F_prefetched
F_pfB:
    s_mov_b32 s4, 0xc0000000
    s_mul_i32 s3, s2, 11904
    s_add_u32 s3, s3, 2097152
    v_and_b32 v167, 63, v0
    v_lshl_add_u32 v167, v167, 7, s3
    buffer_load_dword v166, v167, s[20:23], 0 offen
    v_add_u32 v167, 8192, v167
    s_bfm_b64 exec, 29, 0
    buffer_load_dword v166, v167, s[20:23], 0 offen
    v_add_u32 v167, 8192, v167
    s_mov_b64 exec, -1
    s_branch F_pfB_ret
K2_done:
    s_cmp_lg_u32 s62, 0
    s_cbranch_scc1 K2_next
    s_cmp_eq_u32 s35, 1
    s_cbranch_scc1 K2_next
K2_last:
    s_setprio 3
    s_mov_b32 s66, 0x1000000
K2_guard:
    ds_read_b32 v3, v1
    s_sub_u32 s66, s66, 1
    s_cbranch_scc1 F_end
    s_nop 5
    s_waitcnt lgkmcnt(0)
    v_readfirstlane_b32 s3, v3
    s_cmp_lg_u32 s3, 48
    s_cbranch_scc1 K2_guard
    v_cvt_pk_bf16_f32 v130, v23, v31
    v_cvt_pk_bf16_f32 v131, v38, v46
    ds_write_b64 v12, v[130:131] offset:256
    v_cvt_pk_bf16_f32 v134, v24, v32
    v_cvt_pk_bf16_f32 v135, v54, v62
    ds_write_b64 v12, v[134:135] offset:640
    v_cvt_pk_bf16_f32 v138, v25, v33
    v_cvt_pk_bf16_f32 v139, v70, v78
    ds_write_b64 v12, v[138:139] offset:1024
    v_add_f32 v39, v39, v56
    v_sub_f32 v72, v72, v57
    v_sub_f32 v41, v41, v71
    v_sub_f32 v55, v55, v40
    v_add_f32 v39, v39, v73
    v_add_f32 v47, v47, v64
    v_sub_f32 v80, v80, v65
    v_sub_f32 v49, v49, v79
    v_sub_f32 v63, v63, v48
    v_add_f32 v47, v47, v81
    v_cvt_pk_bf16_f32 v126, v22, v30
    v_cvt_pk_bf16_f32 v127, v39, v47
    ds_write_b64 v12, v[126:127] offset:0
    v_cvt_pk_bf16_f32 v132, v72, v80
    ds_write_b32 v14, v132 offset:512
    v_cvt_pk_bf16_f32 v136, v41, v49
    ds_write_b32 v14, v136 offset:896
    v_cvt_pk_bf16_f32 v140, v55, v63
    ds_write_b32 v14, v140 offset:1280
    v_cvt_pk_bf16_f32 v130, v27, v35
    v_cvt_pk_bf16_f32 v131, v42, v50
    ds_write_b64 v12, v[130:131] offset:3136
    v_cvt_pk_bf16_f32 v134, v28, v36
    v_cvt_pk_bf16_f32 v135, v58, v66
    ds_write_b64 v12, v[134:135] offset:3520
    v_cvt_pk_bf16_f32 v138, v29, v37
    v_cvt_pk_bf16_f32 v139, v74, v82
    ds_write_b64 v12, v[138:139] offset:3904
    v_add_f32 v43, v43, v60
    v_sub_f32 v76, v76, v61
    v_sub_f32 v45, v45, v75
    v_sub_f32 v59, v59, v44
    v_add_f32 v43, v43, v77
    v_add_f32 v51, v51, v68
    v_sub_f32 v84, v84, v69
    v_sub_f32 v53, v53, v83
    v_sub_f32 v67, v67, v52
    v_add_f32 v51, v51, v85
    v_cvt_pk_bf16_f32 v126, v26, v34
    v_cvt_pk_bf16_f32 v127, v43, v51
    ds_write_b64 v12, v[126:127] offset:2880
    v_cvt_pk_bf16_f32 v132, v76, v84
    ds_write_b32 v14, v132 offset:3392
    v_cvt_pk_bf16_f32 v136, v45, v53
    ds_write_b32 v14, v136 offset:3776
    v_cvt_pk_bf16_f32 v140, v59, v67
    ds_write_b32 v14, v140 offset:4160
    v_mov_b32 v1, s60
    s_mov_b64 exec, 1
    ds_add_rtn_u32 v2, v1, v13 offset:0
    s_mov_b64 exec, -1
    s_waitcnt lgkmcnt(0)
    v_readfirstlane_b32 s3, v2
    s_cmp_eq_u32 s3, 12
    s_cbranch_scc1 K2_s1_ok
    s_setprio 0
K2_s1:
    ds_read_b32 v2, v1 offset:0
    s_sub_u32 s66, s66, 1
    s_cbranch_scc1 F_end
    s_waitcnt lgkmcnt(0)
    v_readfirstlane_b32 s3, v2
    s_cmp_lg_u32 s3, 16
    s_cbranch_scc1 K2_s1
K2_s1_ok:
    s_setprio 1
    ds_read_b128 v[22:25], v10 offset:0
    ds_read_b128 v[26:29], v10 offset:64
    ds_read_b128 v[30:33], v10 offset:128
    ds_read_b128 v[34:37], v10 offset:192
    ds_read_b128 v[38:41], v10 offset:256
    ds_read_b128 v[42:45], v10 offset:640
    ds_read_b128 v[46:49], v10 offset:1024
    ds_read_b128 v[50:53], v10 offset:320
    ds_read_b128 v[54:57], v10 offset:704
    ds_read_b128 v[58:61], v10 offset:1088
    ds_read_b128 v[62:65], v10 offset:384
    ds_read_b128 v[66:69], v10 offset:768
    s_cmp_lt_u32 s33, 8
    s_waitcnt lgkmcnt(11)
    v_mfma_f32_16x16x32_bf16 v[142:145], v[86:89], v[22:25], 0
    ds_read_b128 v[70:73], v10 offset:1152
    s_waitcnt lgkmcnt(11)
    v_mfma_f32_16x16x32_bf16 v[142:145], v[90:93], v[26:29], v[142:145]
    ds_read_b128 v[74:77], v10 offset:448
    s_waitcnt lgkmcnt(11)
    v_mfma_f32_16x16x32_bf16 v[142:145], v[94:97], v[30:33], v[142:145]
    ds_read_b128 v[78:81], v10 offset:832
    s_waitcnt lgkmcnt(11)
    v_mfma_f32_16x16x32_bf16 v[142:145], v[98:101], v[34:37], v[142:145]
    ds_read_b128 v[82:85], v10 offset:1216
    s_waitcnt lgkmcnt(11)
    v_mfma_f32_16x16x32_bf16 v[146:149], v[102:105], v[38:41], 0
    ds_read_b128 v[22:25], v10 offset:512
    s_waitcnt lgkmcnt(11)
    v_mfma_f32_16x16x32_bf16 v[150:153], v[102:105], v[42:45], 0
    ds_read_b128 v[26:29], v10 offset:896
    s_waitcnt lgkmcnt(11)
    v_mfma_f32_16x16x32_bf16 v[154:157], v[102:105], v[46:49], 0
    ds_read_b128 v[30:33], v10 offset:1280
    s_waitcnt lgkmcnt(11)
    v_mfma_f32_16x16x32_bf16 v[146:149], v[106:109], v[50:53], v[146:149]
    ds_read_b128 v[34:37], v10 offset:576
    s_cbranch_scc1 K2_g0
    v_add_f32_dpp v142, v142, v142 row_ror:8 row_mask:0xf bank_mask:0xf
    v_add_f32_dpp v143, v143, v143 row_ror:8 row_mask:0xf bank_mask:0xf
    v_add_f32_dpp v144, v144, v144 row_ror:8 row_mask:0xf bank_mask:0xf
    v_add_f32_dpp v145, v145, v145 row_ror:8 row_mask:0xf bank_mask:0xf
K2_g0:
    s_waitcnt lgkmcnt(11)
    v_mfma_f32_16x16x32_bf16 v[150:153], v[106:109], v[54:57], v[150:153]
    ds_read_b128 v[38:41], v10 offset:960
    v_mul_f32 v126, 0xbfb8aa3b, v142
    v_mul_f32 v127, 0xbfb8aa3b, v143
    s_waitcnt lgkmcnt(11)
    v_mfma_f32_16x16x32_bf16 v[154:157], v[106:109], v[58:61], v[154:157]
    ds_read_b128 v[42:45], v10 offset:1344
    v_mul_f32 v128, 0xbfb8aa3b, v144
    v_mul_f32 v129, 0xbfb8aa3b, v145
    s_waitcnt lgkmcnt(11)
    v_mfma_f32_16x16x32_bf16 v[146:149], v[110:113], v[62:65], v[146:149]
    v_exp_f32 v126, v126
    v_exp_f32 v127, v127
    s_waitcnt lgkmcnt(10)
    v_mfma_f32_16x16x32_bf16 v[150:153], v[110:113], v[66:69], v[150:153]
    v_exp_f32 v128, v128
    v_exp_f32 v129, v129
    s_waitcnt lgkmcnt(9)
    v_mfma_f32_16x16x32_bf16 v[154:157], v[110:113], v[70:73], v[154:157]
    v_add_f32 v126, 1.0, v126
    s_waitcnt lgkmcnt(8)
    v_mfma_f32_16x16x32_bf16 v[146:149], v[114:117], v[74:77], v[146:149]
    v_add_f32 v127, 1.0, v127
    s_waitcnt lgkmcnt(7)
    v_mfma_f32_16x16x32_bf16 v[150:153], v[114:117], v[78:81], v[150:153]
    v_add_f32 v128, 1.0, v128
    s_waitcnt lgkmcnt(6)
    v_mfma_f32_16x16x32_bf16 v[154:157], v[114:117], v[82:85], v[154:157]
    v_add_f32 v129, 1.0, v129
    s_waitcnt lgkmcnt(5)
    v_mfma_f32_16x16x32_bf16 v[146:149], v[118:121], v[22:25], v[146:149]
    v_rcp_f32 v126, v126
    s_waitcnt lgkmcnt(4)
    v_mfma_f32_16x16x32_bf16 v[150:153], v[118:121], v[26:29], v[150:153]
    v_rcp_f32 v127, v127
    s_waitcnt lgkmcnt(3)
    v_mfma_f32_16x16x32_bf16 v[154:157], v[118:121], v[30:33], v[154:157]
    v_rcp_f32 v128, v128
    s_waitcnt lgkmcnt(2)
    v_mfma_f32_16x16x32_bf16 v[146:149], v[122:125], v[34:37], v[146:149]
    v_rcp_f32 v129, v129
    s_waitcnt lgkmcnt(1)
    v_mfma_f32_16x16x32_bf16 v[150:153], v[122:125], v[38:41], v[150:153]
    v_cvt_pk_bf16_f32 v130, v142, v143
    s_waitcnt lgkmcnt(0)
    v_mfma_f32_16x16x32_bf16 v[154:157], v[122:125], v[42:45], v[154:157]
    v_cvt_pk_bf16_f32 v131, v144, v145
    ds_write_b64 v11, v[130:131]
    s_cbranch_scc1 K2_g1
    v_add_f32_dpp v146, v146, v146 row_ror:8 row_mask:0xf bank_mask:0xf
    v_add_f32_dpp v147, v147, v147 row_ror:8 row_mask:0xf bank_mask:0xf
    v_add_f32_dpp v148, v148, v148 row_ror:8 row_mask:0xf bank_mask:0xf
    v_add_f32_dpp v149, v149, v149 row_ror:8 row_mask:0xf bank_mask:0xf
    v_add_f32_dpp v150, v150, v150 row_ror:8 row_mask:0xf bank_mask:0xf
    v_add_f32_dpp v151, v151, v151 row_ror:8 row_mask:0xf bank_mask:0xf
    v_add_f32_dpp v152, v152, v152 row_ror:8 row_mask:0xf bank_mask:0xf
    v_add_f32_dpp v153, v153, v153 row_ror:8 row_mask:0xf bank_mask:0xf
    v_add_f32_dpp v154, v154, v154 row_ror:8 row_mask:0xf bank_mask:0xf
    v_add_f32_dpp v155, v155, v155 row_ror:8 row_mask:0xf bank_mask:0xf
    v_add_f32_dpp v156, v156, v156 row_ror:8 row_mask:0xf bank_mask:0xf
    v_add_f32_dpp v157, v157, v157 row_ror:8 row_mask:0xf bank_mask:0xf
K2_g1:
    v_mul_f32 v146, v126, v146
    v_mul_f32 v147, v127, v147
    v_mul_f32 v148, v128, v148
    v_mul_f32 v149, v129, v149
    v_cvt_pk_bf16_f32 v146, v146, v147
    v_cvt_pk_bf16_f32 v147, v148, v149
    ds_write_b64 v11, v[146:147] offset:128
    v_mul_f32 v150, v126, v150
    v_mul_f32 v151, v127, v151
    v_mul_f32 v152, v128, v152
    v_mul_f32 v153, v129, v153
    v_cvt_pk_bf16_f32 v150, v150, v151
    v_cvt_pk_bf16_f32 v151, v152, v153
    ds_write_b64 v11, v[150:151] offset:256
    v_mul_f32 v154, v126, v154
    v_mul_f32 v155, v127, v155
    v_mul_f32 v156, v128, v156
    v_mul_f32 v157, v129, v157
    v_cvt_pk_bf16_f32 v154, v154, v155
    v_cvt_pk_bf16_f32 v155, v156, v157
    ds_write_b64 v11, v[154:155] offset:384
    v_mov_b32 v1, s60
    s_mov_b64 exec, 1
    ds_add_rtn_u32 v2, v1, v13 offset:16
    s_mov_b64 exec, -1
    ds_read_b128 v[22:25], v15
    ds_read_b128 v[26:29], v15 offset:4224
    s_waitcnt lgkmcnt(2)
    v_readfirstlane_b32 s3, v2
    s_cmp_eq_u32 s3, 12
    s_cbranch_scc1 K2_s2_ok
    s_setprio 0
K2_s2:
    ds_read_b32 v2, v1 offset:16
    ds_read_b128 v[22:25], v15
    ds_read_b128 v[26:29], v15 offset:4224
    s_sub_u32 s66, s66, 1
    s_cbranch_scc1 F_end
    s_waitcnt lgkmcnt(2)
    v_readfirstlane_b32 s3, v2
    s_cmp_lg_u32 s3, 16
    s_cbranch_scc1 K2_s2
K2_s2_ok:
    s_setprio 1
    s_cmp_ge_u32 s33, 8
    s_mov_b32 s3, 1048576
    s_waitcnt lgkmcnt(1)
    buffer_store_dwordx4 v[22:25], v5, s[24:27], 0 offen sc1 nt
    s_cbranch_scc1 K2_fin
    s_waitcnt lgkmcnt(0)
    buffer_store_dwordx4 v[26:29], v5, s[24:27], s3 offen sc1 nt
K2_fin:
F_end:
    s_endpgm
F_tagA:
    s_mov_b32 s66, 0x40000
    v_mov_b32 v1, 0
F_tagA_l:
    global_load_dword v2, v1, s[18:19] sc1
    s_waitcnt vmcnt(0)
    v_readfirstlane_b32 s43, v2
    s_cmp_lg_u32 s43, 0
    s_cbranch_scc1 F_out
    s_sub_u32 s66, s66, 1
    s_cbranch_scc0 F_tagA_l
    s_endpgm
F_tagD:
    s_mov_b32 s66, 0x40000
    v_mov_b32 v1, 0
F_tagD_l:
    global_load_dword v2, v1, s[18:19] sc1
    s_waitcnt vmcnt(0)
    v_readfirstlane_b32 s43, v2
    s_cmp_lg_u32 s43, 0
    s_cbranch_scc1 F_tagD_ret
    s_sub_u32 s66, s66, 1
    s_cbranch_scc0 F_tagD_l
    s_endpgm
F_repoll:
    buffer_load_dwordx2 v[4:5], v15, s[28:31], 0 offen sc1
    s_sub_u32 s66, s66, 1
    s_waitcnt vmcnt(0)
    s_cbranch_scc0 F_poll
    s_endpgm
F_retry:
    s_mov_b64 exec, s[4:5]
    s_cbranch_execz F_retry0
    v_or_b32 v129, 60, v158
    buffer_load_dword v129, v129, s[28:31], 0 offen sc1
    buffer_load_dwordx3 v[126:128], v158, s[28:31], 0 offen sc1
F_retry0:
    s_mov_b64 exec, s[6:7]
    s_cbranch_execz F_retry1
    v_or_b32 v133, 60, v159
    buffer_load_dword v133, v133, s[28:31], 0 offen sc1
    buffer_load_dwordx3 v[130:132], v159, s[28:31], 0 offen sc1
F_retry1:
    s_mov_b64 exec, s[8:9]
    s_cbranch_execz F_retry2
    v_or_b32 v137, 60, v160
    buffer_load_dword v137, v137, s[28:31], 0 offen sc1
    buffer_load_dwordx3 v[134:136], v160, s[28:31], 0 offen sc1
F_retry2:
    s_mov_b64 exec, s[10:11]
    s_cbranch_execz F_retry3
    v_or_b32 v141, 60, v161
    buffer_load_dword v141, v141, s[28:31], 0 offen sc1
    buffer_load_dwordx3 v[138:140], v161, s[28:31], 0 offen sc1
F_retry3:
    s_mov_b64 exec, s[12:13]
    s_cbranch_execz F_retry4
    v_or_b32 v145, 60, v162
    buffer_load_dword v145, v145, s[28:31], 0 offen sc1
    buffer_load_dwordx3 v[142:144], v162, s[28:31], 0 offen sc1
F_retry4:
    s_mov_b64 exec, s[14:15]
    s_cbranch_execz F_retry5
    v_or_b32 v149, 60, v163
    buffer_load_dword v149, v149, s[28:31], 0 offen sc1
    buffer_load_dwordx3 v[146:148], v163, s[28:31], 0 offen sc1
F_retry5:
    s_mov_b64 exec, s[16:17]
    s_cbranch_execz F_retry6
    v_or_b32 v153, 60, v164
    buffer_load_dword v153, v153, s[28:31], 0 offen sc1
    buffer_load_dwordx3 v[150:152], v164, s[28:31], 0 offen sc1
F_retry6:
    s_waitcnt vmcnt(0)
    s_sub_u32 s66, s66, 1
    s_cbranch_scc0 F_sweep
    s_endpgm
K2_x1:
    v_add_u32_dpp v165, v8, v11 row_newbcast:1 row_mask:0xf bank_mask:0xf
    v_sub_u32_dpp v1, v9, v11 row_newbcast:1 row_mask:0xf bank_mask:0xf
    v_mul_hi_u32 v2, v165, s1
    v_cmp_lt_i32 s[58:59], 0, v1
    v_mad_u32_u24 v165, v165, 3, v2
    v_lshlrev_b32 v165, 2, v165
    v_or_b32 v157, 60, v165
    s_or_b64 exec, s[58:59], 1
    buffer_load_dword v157, v157, s[28:31], 0 offen
    buffer_load_dwordx3 v[154:156], v165, s[28:31], 0 offen
    s_mov_b64 exec, -1
    s_mov_b64 s[18:19], s[58:59]
K2_x1_l:
    s_waitcnt vmcnt(0)
    s_mov_b64 exec, s[18:19]
    v_and_or_b32 v1, v156, s69, v157
    v_cmpx_eq_u32 vcc, s43, v1
    v_bfe_u32 v165, v156, 20, 10
    v_add_u32 v1, 352321536, v15
    s_andn2_b64 s[18:19], s[18:19], exec
    ds_add_rtn_u32 v157, v165, v13 offset:0
    ds_write_b64 v12, v[154:155] offset:43008
    v_and_or_b32 v156, v156, s40, v1
    s_mov_b64 exec, s[18:19]
    s_cbranch_execz K2_x1_ok
    v_or_b32 v157, 60, v165
    buffer_load_dword v157, v157, s[28:31], 0 offen sc1
    buffer_load_dwordx3 v[154:156], v165, s[28:31], 0 offen sc1
    s_sub_u32 s66, s66, 1
    s_cbranch_scc0 K2_x1_l
    s_endpgm
K2_x1_ok:
    s_waitcnt lgkmcnt(0)
    s_andn2_b64 s[70:71], s[58:59], s[18:19]
    s_mov_b64 exec, s[70:71]
    v_cmpx_gt_u32 vcc, s32, v157
    v_mad_u32_u24 v2, v165, 52, v157
    s_xor_b64 s[70:71], s[70:71], exec
    ds_write_b32 v2, v156 offset:1088
    s_or_b64 s[72:73], s[72:73], s[70:71]
    s_mov_b64 exec, -1
    s_cmp_le_u32 s39, 8
    s_cbranch_scc1 K2_x1_ret
    s_mov_b64 s[72:73], -1
    s_branch K2_x1_ret
K2_setmore:
    v_mov_b32 v1, 1024
    ds_write_b32 v1, v13 offset:4
    s_branch K2_setmore_ret
K2_setslow:
    s_mov_b64 exec, -1
    v_mov_b32 v1, 1024
    ds_write_b32 v1, v13
    s_branch K2_setslow_ret
K2_goslow:
    s_cmp_eq_u32 s35, 1
    s_cbranch_scc1 F_end
    s_movk_i32 s35, 1
    s_mov_b32 s64, 0x00010001
    s_mov_b32 s65, 0x00010001
    s_branch K2_again
K2_next:
    s_cmp_lg_u32 s35, 1
    s_cbranch_scc1 K2_advance
    s_lshl_b64 s[64:65], s[64:65], 1
    s_cmp_lg_u32 s64, 0x00400040
    s_cbranch_scc1 K2_again
    s_cmp_eq_u32 s62, 0
    s_cbranch_scc1 K2_last
    s_mov_b32 s64, 0x00010001
    s_mov_b32 s65, 0x00010001
K2_advance:
    s_add_u32 s34, s34, s35
K2_again:
    s_nop 7
    s_nop 7
    s_waitcnt vmcnt(0) lgkmcnt(0)
    s_barrier
    v_and_b32 v11, 15, v0
    v_lshrrev_b32 v1, 4, v0
    v_mad_u32_u24 v5, v11, 48, v1
    v_mul_u32_u24 v10, 2500, v5
    v_lshlrev_b32 v12, 3, v0
    v_add_u32 v12, 41024, v12
    s_lshl_b32 s3, s33, 4
    v_add_lshl_u32 v14, v11, s3, 2
    s_mul_i32 s38, s33, 3328
    s_add_u32 s38, s38, 1088
    v_bfe_u32 v1, v0, 5, 1
    v_lshl_add_u32 v19, v1, 4, s38
    v_lshl_add_u32 v20, v1, 5, s38
    v_and_b32 v1, 12, v0
    v_add_u32 v20, v20, v1
    v_lshlrev_b32 v1, 2, v0
    v_min_u32 v1, 1084, v1
    v_mov_b32 v2, 0
    v_mov_b32 v3, 0
    ds_write_b32 v1, v2 offset:0
    v_mov_b32 v1, 90176
    ds_write_b64 v1, v[2:3]
    v_lshl_add_u32 v1, v11, 2, s38
    v_mov_b32 v2, 0x1800ffff
    ds_write_b32 v1, v2
    s_mov_b32 s66, 0x40000
    s_mov_b64 s[72:73], 0
    s_waitcnt lgkmcnt(0)
    s_barrier
F_last:
    s_branch F_polled
.section .rodata,"a"
.p2align 6
.amdhsa_kernel standalone__tensor_product_equiv_equiformer__graph_kernel
  .amdhsa_next_free_vgpr 168
  .amdhsa_next_free_sgpr 102
  .amdhsa_accum_offset 168
  .amdhsa_group_segment_fixed_size 0
  .amdhsa_kernarg_size 96
  .amdhsa_user_sgpr_count 2
  .amdhsa_user_sgpr_kernarg_segment_ptr 1
  .amdhsa_system_sgpr_workgroup_id_x 1
.end_amdhsa_kernel
```
